```python
import torch

def _softmax(x, axis=-1):
    return torch.softmax(x, dim=axis)
def _gelu(x):
    return torch.nn.functional.gelu(x, approximate="tanh")
def _silu(x):
    return torch.nn.functional.silu(x)
def _sigmoid(x):
    return torch.sigmoid(x)
def _layernorm(x, axis=-1, eps=1e-5):
    m = x.mean(dim=axis, keepdim=True)
    v = x.var(dim=axis, keepdim=True, unbiased=False)
    return (x - m) / torch.sqrt(v + eps)
def _scatter_add(tgt, idx, src, axis=0):
    return tgt.clone().index_add_(axis, idx, src)
def _segment_sum(src, seg, n):
    out = torch.zeros((n,) + src.shape[1:], dtype=src.dtype)
    return out.index_add_(0, seg, src)
def _pad(x, pw):
    flat = tuple(v for pair in reversed(pw) for v in pair)
    return torch.nn.functional.pad(x, flat)

kernel_name = 'parallel_sum__sliding_block_cached__glu_gated_geglu__decode'

def setup_inputs():

    _w = (lambda a: (lambda t: t.to(torch.bfloat16) if t.is_floating_point() else t)(torch.as_tensor(a)))
    def _A_setup():
        B, Sq, D = 4, 1, 512
        Hq, Hkv, Sk, Dh = 32, 8, 4096, 128
        assert Hq % Hkv == 0, (Hq, Hkv)
        return {
            "x": _w((lambda *s: torch.randn(*s, dtype=torch.bfloat16) * 0.05)(B, Sq, D)),
            "k_cache": _w((lambda *s: torch.randn(*s, dtype=torch.bfloat16) * 1.6)(B, Hkv, Sk, Dh)),
            "v_cache": _w((lambda *s: torch.randn(*s, dtype=torch.bfloat16) * 0.8)(B, Hkv, Sk, Dh)),
            "wq": _w((lambda *s: torch.randn(*s, dtype=torch.bfloat16) * 1.6)(D, Hq * Dh) * (D ** -0.5)),
            "wo": _w((lambda *s: torch.randn(*s, dtype=torch.bfloat16) * 0.8)(Hq * Dh, D) * ((Hq * Dh) ** -0.5)),
        }
    _A_in = _A_setup()

    def _B_setup():
        B, S, Dm, Df = 4, 1, 512, 1792
        return {
            "x": _w((lambda *s: torch.randn(*s, dtype=torch.bfloat16) * 0.05)(B, S, Dm)),
            "w_gate": _w((lambda *s: torch.randn(*s, dtype=torch.bfloat16) * 0.8)(Dm, Df) * (Dm ** -0.5)),
            "w_up": _w((lambda *s: torch.randn(*s, dtype=torch.bfloat16) * 0.8)(Dm, Df) * (Dm ** -0.5)),
            "w_down": _w((lambda *s: torch.randn(*s, dtype=torch.bfloat16) * 0.8)(Df, Dm) * (Df ** -0.5)),
        }
    _B_in = _B_setup()

    return {
        "A_x": _A_in["x"],
        "A_k_cache": _A_in["k_cache"],
        "A_v_cache": _A_in["v_cache"],
        "A_wq": _A_in["wq"],
        "A_wo": _A_in["wo"],
        "B_x": _B_in["x"],
        "B_w_gate": _B_in["w_gate"],
        "B_w_up": _B_in["w_up"],
        "B_w_down": _B_in["w_down"],
    }

def reference(A_x, A_k_cache, A_v_cache, A_wq, A_wo, B_x, B_w_gate, B_w_up, B_w_down):
    def _A_ref(x, k_cache, v_cache, wq, wo):
        B, Sq, D = x.shape
        Hq, Dh = 32, 128
        Hkv, Sk = k_cache.shape[1], k_cache.shape[2]
        W = min(4096, max(256, Sk // 4))
        rep = Hq // Hkv
        q = (lambda x, *d: x.permute(*d))((x @ wq).reshape(B, Sq, Hq, Dh), 0, 2, 1, 3)
        k = (lambda x, n, axis: torch.repeat_interleave(x, n, dim=axis))(k_cache[:, :, Sk - W:, :], rep, axis=1)
        v = (lambda x, n, axis: torch.repeat_interleave(x, n, dim=axis))(v_cache[:, :, Sk - W:, :], rep, axis=1)
        scores = torch.einsum("bhqd,bhkd->bhqk", q, k) * (Dh ** -0.5)
        p = _softmax(scores, axis=-1)
        o = torch.einsum("bhqk,bhkd->bhqd", p, v)
        return (lambda x, *d: x.permute(*d))(o, 0, 2, 1, 3).reshape(B, Sq, Hq * Dh) @ wo

    def _B_ref(x, w_gate, w_up, w_down):
        g = torch.einsum("bsd,df->bsf", x, w_gate)
        u = torch.einsum("bsd,df->bsf", x, w_up)
        h = _gelu(g) * u
        return torch.einsum("bsf,fd->bsd", h, w_down)

    x = A_x
    xn = _layernorm(x, axis=-1)
    return x + _A_ref(xn, A_k_cache, A_v_cache, A_wq, A_wo) + _B_ref(xn, B_w_gate, B_w_up, B_w_down)
```

```asm
; @launch grid=(256,1,1) block=(512,1,1) lds=69568
.amdgcn_target "amdgcn-amd-amdhsa--gfx950"
.text
.p2align 11
.globl parallel_sum__sliding_block_cached__glu_gated_geglu__decode_kernel
.p2align 8
.type parallel_sum__sliding_block_cached__glu_gated_geglu__decode_kernel,@function
parallel_sum__sliding_block_cached__glu_gated_geglu__decode_kernel:

s_cmp_ge_u32 s2, 256
s_cbranch_scc1 L_end
s_getpc_b64 s[64:65]
L_pc0:
s_load_dwordx16 s[4:19], s[0:1], 0
s_load_dwordx8 s[20:27], s[0:1], 64
v_lshrrev_b32 v2, 6, v0
v_and_b32 v1, 63, v0
s_and_b32 s29, s2, 7
s_lshr_b32 s30, s2, 3
v_readfirstlane_b32 s28, v2
s_cmp_eq_u32 s28, 3
s_cbranch_scc0 L_nocpf
s_mul_i32 s34, s30, 384
v_lshlrev_b32 v3, 4, v1
v_add_u32 v3, s34, v3
s_mov_b32 s35, L_end-L_pc0-12
v_cmp_gt_u32 vcc, 24, v1
s_and_saveexec_b64 s[66:67], vcc
v_cmp_gt_u32 vcc, s35, v3
s_and_b64 exec, exec, vcc
s_cbranch_execz L_cpf_skip
v_mov_b32 v9, s65
v_add_co_u32 v8, vcc, s64, v3
s_nop 1
v_addc_co_u32 v9, vcc, 0, v9, vcc
global_load_dwordx4 v[160:163], v[8:9], off
L_cpf_skip:
s_mov_b64 exec, -1
L_nocpf:
s_mov_b32 s62, 16777216
s_mov_b32 s61, 0
s_and_b32 s31, s28, 3
v_lshrrev_b32 v4, 4, v1
v_and_b32 v5, 15, v1
s_cmp_lt_u32 s28, 4
s_cbranch_scc1 L_roleB
v_mov_b32 v2, 69504
v_mov_b32 v8, 0
v_mov_b32 v9, 0
v_mov_b32 v10, 0
v_mov_b32 v11, 0
ds_write_b128 v2, v[8:11]
ds_write_b128 v2, v[8:11] offset:16
ds_write_b128 v2, v[8:11] offset:32
s_lshr_b32 s56, s30, 3
s_and_b32 s34, s30, 7
s_lshl_b32 s34, s34, 7
s_lshl_b32 s57, s29, 10
s_add_u32 s57, s57, s34
v_lshrrev_b32 v6, 3, v1
v_and_b32 v7, 7, v1
v_lshlrev_b32 v9, 1, v4
v_xor_b32 v7, v7, v9
v_lshlrev_b32 v3, 4, v7
v_lshl_add_u32 v8, v6, 13, v3
v_add_u32 v8, s57, v8
s_lshl_b32 s48, s56, 7
s_lshl_b32 s34, s31, 5
s_add_u32 s49, s48, s34
s_lshl_b32 s48, s49, 13
s_lshl_b32 s50, s31, 12
v_lshlrev_b32 v10, 4, v1
s_lshl_b32 s34, s31, 10
v_add_u32 v10, s34, v10
s_waitcnt lgkmcnt(0)
s_mov_b32 s40, s4
s_and_b32 s41, s5, 0xffff
s_mov_b32 s42, 4096
s_mov_b32 s43, 0x20000
s_mov_b32 s44, s10
s_and_b32 s45, s11, 0xffff
s_mov_b32 s46, 4194304
s_mov_b32 s47, 0x20000
buffer_load_dwordx4 v[16:19], v10, s[40:43], 0 offen
s_add_u32 m0, s50, 0
s_nop 0
buffer_load_dwordx4 v8, s[44:47], s48 offen nt lds
s_add_u32 m0, s50, 1024
s_add_u32 s48, s48, 65536
buffer_load_dwordx4 v8, s[44:47], s48 offen nt lds
s_add_u32 m0, s50, 2048
s_add_u32 s48, s48, 65536
buffer_load_dwordx4 v8, s[44:47], s48 offen nt lds
s_add_u32 m0, s50, 3072
s_add_u32 s48, s48, 65536
buffer_load_dwordx4 v8, s[44:47], s48 offen nt lds
s_load_dword s33, s[26:27], 0
s_mov_b32 s36, s26
s_and_b32 s37, s27, 0xffff
s_mov_b32 s38, 268435456
s_mov_b32 s39, 0x20000
s_barrier
s_branch L_A_main
L_roleB:
s_mov_b32 s52, 4096
s_mov_b32 s53, 0x05040100
s_mov_b32 s54, 0x07060302
s_lshr_b32 s34, s30, 3
s_and_b32 s56, s30, 7
s_lshl_b32 s35, s34, 3
s_add_u32 s35, s35, s29
s_lshl_b32 s35, s35, 20
s_lshl_b32 s57, s56, 15
s_add_u32 s35, s35, s57
s_lshl_b32 s57, s31, 13
s_add_u32 s35, s35, s57
s_add_u32 s35, s35, 786432
v_lshlrev_b32 v6, 8, v5
v_lshl_add_u32 v6, v4, 4, v6
v_add_u32 v6, s35, v6
v_lshlrev_b32 v7, 4, v5
v_lshl_add_u32 v7, v4, 10, v7
v_add_u32 v7, s35, v7
v_lshlrev_b32 v15, 3, v1
s_lshl_b32 s57, s29, 2
s_add_u32 s57, s57, s31
s_lshl_b32 s57, s57, 5
s_add_u32 s57, s57, s30
s_lshl_b32 s58, s57, 9
s_add_u32 s58, s58, 1179648
v_add_u32 v13, s58, v15
s_lshl_b32 s58, s57, 3
s_add_u32 s58, s58, 1114112
v_mov_b32 v14, s58
s_waitcnt lgkmcnt(0)
s_mov_b32 s40, s6
s_and_b32 s41, s7, 0xffff
s_mov_b32 s42, 33554432
s_mov_b32 s43, 0x20000
s_mov_b32 s44, s8
s_and_b32 s45, s9, 0xffff
s_mov_b32 s46, 33554432
s_mov_b32 s47, 0x20000
s_mov_b32 s36, s26
s_and_b32 s37, s27, 0xffff
s_mov_b32 s38, 268435456
s_mov_b32 s39, 0x20000
s_load_dword s33, s[26:27], 0
s_barrier
buffer_load_dwordx4 v[16:19], v6, s[40:43], 0 offen offset:0 nt
buffer_load_dwordx4 v[20:23], v6, s[40:43], 0 offen offset:64 nt
buffer_load_dwordx4 v[24:27], v6, s[40:43], 0 offen offset:128 nt
buffer_load_dwordx4 v[28:31], v6, s[40:43], 0 offen offset:192 nt
buffer_load_dwordx4 v[32:35], v6, s[40:43], s52 offen offset:0 nt
buffer_load_dwordx4 v[36:39], v6, s[40:43], s52 offen offset:64 nt
s_cmp_eq_u32 s31, 3
s_cbranch_scc0 L_B_noloc
s_waitcnt lgkmcnt(0)
s_mul_i32 s32, s33, 0x9E3779B1
s_add_u32 s32, s32, 0x7F4A7C15
s_or_b32 s32, s32, 1
s_getreg_b32 s57, hwreg(HW_REG_XCC_ID)
s_lshl_b32 s58, s29, 8
s_lshl_b32 s59, s30, 3
s_add_u32 s58, s58, s59
s_add_u32 s58, s58, 32768
v_mov_b32 v10, s57
v_mov_b32 v11, s32
v_mov_b32 v12, s58
s_mov_b64 exec, 1
buffer_store_dwordx2 v[10:11], v12, s[36:39], 0 offen sc1
s_mov_b64 exec, -1
L_B_noloc:
s_waitcnt vmcnt(5)
buffer_load_dwordx4 v[40:43], v6, s[40:43], s52 offen offset:128 nt
s_waitcnt vmcnt(5)
buffer_load_dwordx4 v[44:47], v6, s[40:43], s52 offen offset:192 nt
s_waitcnt vmcnt(5)
buffer_load_dwordx4 v[48:51], v7, s[44:47], 0 offen offset:0 nt
s_waitcnt vmcnt(5)
buffer_load_dwordx4 v[52:55], v7, s[44:47], 0 offen offset:256 nt
s_waitcnt vmcnt(5)
s_mov_b64 exec, 1
v_mov_b32 v166, 69504
v_mov_b32 v167, 1
ds_add_u32 v166, v167
s_mov_b64 exec, -1
buffer_load_dwordx4 v[56:59], v7, s[44:47], 0 offen offset:512 nt
s_waitcnt vmcnt(5)
buffer_load_dwordx4 v[60:63], v7, s[44:47], 0 offen offset:768 nt
s_waitcnt vmcnt(5)
buffer_load_dwordx4 v[64:67], v7, s[44:47], s52 offen offset:0 nt
s_waitcnt vmcnt(5)
buffer_load_dwordx4 v[68:71], v7, s[44:47], s52 offen offset:256 nt
s_waitcnt vmcnt(5)
buffer_load_dwordx4 v[72:75], v7, s[44:47], s52 offen offset:512 nt
s_waitcnt vmcnt(5)
buffer_load_dwordx4 v[76:79], v7, s[44:47], s52 offen offset:768 nt
s_mov_b64 exec, 1
v_mov_b32 v166, 69508
v_mov_b32 v167, 1
ds_add_u32 v166, v167
s_mov_b64 exec, -1
v_and_b32 v6, 3, v1
v_mul_u32_u24 v7, 320, v6
v_lshl_add_u32 v7, v4, 4, v7
v_add_u32 v7, 58624, v7
s_mul_i32 s57, s31, 2112
s_add_u32 s57, s57, 59904
v_mul_u32_u24 v8, 528, v6
v_lshl_add_u32 v8, v4, 7, v8
v_add_u32 v8, s57, v8
s_lshl_b32 s57, s31, 5
s_add_u32 s57, s57, 68352
v_lshlrev_b32 v9, 3, v6
v_add_u32 v9, s57, v9
s_mul_i32 s57, s31, 528
s_add_u32 s57, s57, 59904
v_add_u32 v164, s57, v15
s_lshl_b32 s57, s31, 3
s_add_u32 s57, s57, 68352
v_mov_b32 v12, s57
v_mov_b32 v120, 0x3f803f80
v_mov_b32 v121, 0x3f803f80
v_mov_b32 v122, 0x3f803f80
v_mov_b32 v123, 0x3f803f80
s_mov_b32 s55, 0x3e0293ee
s_mov_b32 s60, 0
v_mov_b32 v166, 69512
L_w1:
ds_read_b32 v167, v166
s_waitcnt lgkmcnt(0)
v_readfirstlane_b32 s34, v167
s_add_u32 s60, s60, 1
s_cmp_ge_u32 s60, 1048576
s_cbranch_scc1 L_fail8
s_cmp_ge_u32 s34, 4
s_cbranch_scc1 L_w1_ok
s_sleep 1
s_branch L_w1
L_w1_ok:
ds_read_b128 v[80:83], v7 offset:0
ds_read_b128 v[84:87], v7 offset:64
ds_read_b128 v[88:91], v7 offset:128
ds_read_b128 v[92:95], v7 offset:192
v_mov_b32 v10, 69536
ds_read_b32 v11, v10
s_waitcnt lgkmcnt(0)
s_mul_i32 s32, s33, 0x9E3779B1
s_add_u32 s32, s32, 0x7F4A7C15
s_or_b32 s32, s32, 1
v_readfirstlane_b32 s57, v11
s_cmp_eq_u32 s57, 1
s_cselect_b32 s63, 0x20000000, s62
s_waitcnt vmcnt(8)
v_mfma_f32_16x16x32_bf16 v[96:99], v[16:19], v[80:83], 0
v_mfma_f32_16x16x32_bf16 v[100:103], v[32:35], v[80:83], 0
v_mfma_f32_16x16x32_bf16 v[96:99], v[20:23], v[84:87], v[96:99]
v_mfma_f32_16x16x32_bf16 v[100:103], v[36:39], v[84:87], v[100:103]
v_mfma_f32_16x16x32_bf16 v[96:99], v[24:27], v[88:91], v[96:99]
v_mfma_f32_16x16x32_bf16 v[100:103], v[40:43], v[88:91], v[100:103]
v_mfma_f32_16x16x32_bf16 v[96:99], v[28:31], v[92:95], v[96:99]
v_mfma_f32_16x16x32_bf16 v[100:103], v[44:47], v[92:95], v[100:103]
s_nop 7
v_max3_f32 v16, v96, v97, v98
v_max3_f32 v17, v99, v100, v101
v_max3_f32 v16, v16, v102, v103
v_max_f32 v16, v16, v17
v_mov_b32 v17, v16
s_nop 1
v_permlane16_swap_b32 v16, v17
v_max_f32 v16, v16, v17
v_mov_b32 v17, v16
s_nop 1
v_permlane32_swap_b32 v16, v17
v_max_f32 v16, v16, v17
v_mul_f32 v18, s55, v16
v_fma_f32 v20, v96, s55, -v18
v_fma_f32 v21, v97, s55, -v18
v_fma_f32 v22, v98, s55, -v18
v_fma_f32 v23, v99, s55, -v18
v_fma_f32 v24, v100, s55, -v18
v_fma_f32 v25, v101, s55, -v18
v_fma_f32 v26, v102, s55, -v18
v_fma_f32 v27, v103, s55, -v18
v_exp_f32 v20, v20
v_exp_f32 v21, v21
v_exp_f32 v22, v22
v_exp_f32 v23, v23
v_exp_f32 v24, v24
v_exp_f32 v25, v25
v_exp_f32 v26, v26
v_exp_f32 v27, v27
s_nop 0
v_cvt_pk_bf16_f32 v116, v20, v21
v_cvt_pk_bf16_f32 v117, v22, v23
v_cvt_pk_bf16_f32 v118, v24, v25
v_cvt_pk_bf16_f32 v119, v26, v27
s_nop 1
v_mfma_f32_16x16x32_bf16 v[160:163], v[120:123], v[116:119], 0
s_waitcnt vmcnt(0)
v_perm_b32 v104, v52, v48, s53
v_perm_b32 v105, v60, v56, s53
v_perm_b32 v106, v68, v64, s53
v_perm_b32 v107, v76, v72, s53
v_perm_b32 v108, v52, v48, s54
v_perm_b32 v109, v60, v56, s54
v_perm_b32 v110, v68, v64, s54
v_perm_b32 v111, v76, v72, s54
v_mfma_f32_16x16x32_bf16 v[128:131], v[104:107], v[116:119], 0
v_perm_b32 v112, v53, v49, s53
v_perm_b32 v113, v61, v57, s53
v_perm_b32 v114, v69, v65, s53
v_perm_b32 v115, v77, v73, s53
v_mfma_f32_16x16x32_bf16 v[132:135], v[108:111], v[116:119], 0
v_perm_b32 v104, v53, v49, s54
v_perm_b32 v105, v61, v57, s54
v_perm_b32 v106, v69, v65, s54
v_perm_b32 v107, v77, v73, s54
v_mfma_f32_16x16x32_bf16 v[136:139], v[112:115], v[116:119], 0
v_perm_b32 v108, v54, v50, s53
v_perm_b32 v109, v62, v58, s53
v_perm_b32 v110, v70, v66, s53
v_perm_b32 v111, v78, v74, s53
v_mfma_f32_16x16x32_bf16 v[140:143], v[104:107], v[116:119], 0
v_perm_b32 v112, v54, v50, s54
v_perm_b32 v113, v62, v58, s54
v_perm_b32 v114, v70, v66, s54
v_perm_b32 v115, v78, v74, s54
v_mfma_f32_16x16x32_bf16 v[144:147], v[108:111], v[116:119], 0
v_perm_b32 v104, v55, v51, s53
v_perm_b32 v105, v63, v59, s53
v_perm_b32 v106, v71, v67, s53
v_perm_b32 v107, v79, v75, s53
v_mfma_f32_16x16x32_bf16 v[148:151], v[112:115], v[116:119], 0
v_perm_b32 v108, v55, v51, s54
v_perm_b32 v109, v63, v59, s54
v_perm_b32 v110, v71, v67, s54
v_perm_b32 v111, v79, v75, s54
v_mfma_f32_16x16x32_bf16 v[152:155], v[104:107], v[116:119], 0
s_nop 1
v_mfma_f32_16x16x32_bf16 v[156:159], v[108:111], v[116:119], 0
v_mov_b32 v17, v160
s_mov_b32 exec_lo, 0x000f000f
s_mov_b32 exec_hi, 0x000f000f
ds_write_b64 v9, v[16:17]
ds_write_b128 v8, v[128:131] offset:0
ds_write_b128 v8, v[132:135] offset:16
ds_write_b128 v8, v[136:139] offset:32
ds_write_b128 v8, v[140:143] offset:48
ds_write_b128 v8, v[144:147] offset:64
ds_write_b128 v8, v[148:151] offset:80
ds_write_b128 v8, v[152:155] offset:96
s_nop 3
ds_write_b128 v8, v[156:159] offset:112
s_mov_b64 exec, 1
v_mov_b32 v10, 69516
v_mov_b32 v11, 1
ds_add_u32 v10, v11
s_mov_b64 exec, -1
s_mov_b32 s60, 0
v_mov_b32 v10, 69516
L_w2:
ds_read_b32 v11, v10
s_waitcnt lgkmcnt(0)
v_readfirstlane_b32 s34, v11
s_add_u32 s60, s60, 1
s_cmp_ge_u32 s60, 1048576
s_cbranch_scc1 L_fail6
s_cmp_ge_u32 s34, 4
s_cbranch_scc1 L_w2_ok
s_branch L_w2
L_w2_ok:
ds_read2_b64 v[20:23], v12 offset0:0 offset1:4
ds_read2_b64 v[24:27], v12 offset0:8 offset1:12
ds_read_b64 v[32:33], v164 offset:0
ds_read_b64 v[34:35], v164 offset:2112
ds_read_b64 v[36:37], v164 offset:4224
ds_read_b64 v[38:39], v164 offset:6336
s_waitcnt lgkmcnt(4)
v_max3_f32 v28, v20, v22, v24
v_max_f32 v28, v28, v26
v_mul_f32 v29, s55, v28
v_fma_f32 v40, v20, s55, -v29
v_fma_f32 v41, v22, s55, -v29
v_fma_f32 v42, v24, s55, -v29
v_fma_f32 v43, v26, s55, -v29
v_exp_f32 v40, v40
v_exp_f32 v41, v41
v_exp_f32 v42, v42
v_exp_f32 v43, v43
s_nop 0
v_mul_f32 v30, v40, v21
v_fmac_f32 v30, v41, v23
v_fmac_f32 v30, v42, v25
v_fmac_f32 v30, v43, v27
v_rcp_f32 v31, v30
v_log_f32 v44, v30
s_waitcnt lgkmcnt(0)
v_mul_f32 v46, v40, v32
v_mul_f32 v47, v40, v33
v_fmac_f32 v46, v41, v34
v_fmac_f32 v47, v41, v35
v_fmac_f32 v46, v42, v36
v_fmac_f32 v47, v42, v37
v_fmac_f32 v46, v43, v38
v_fmac_f32 v47, v43, v39
v_mul_f32 v46, v46, v31
v_mul_f32 v47, v47, v31
v_add_f32 v44, v44, v29
v_mov_b32 v49, s32
v_mov_b32 v45, s32
v_cvt_pk_bf16_f32 v48, v46, v47
buffer_store_dwordx2 v[48:49], v13, s[36:39], 0 offen
s_mov_b64 exec, 1
buffer_store_dwordx2 v[44:45], v14, s[36:39], 0 offen
buffer_store_dwordx2 v[44:45], v14, s[36:39], s63 offen sc1
s_mov_b64 exec, -1
buffer_store_dwordx2 v[48:49], v13, s[36:39], s63 offen sc1
s_endpgm
L_A_main:
s_and_b32 s34, s30, 3
s_and_b32 s35, s29, 1
s_lshl_b32 s58, s34, 7
s_lshl_b32 s59, s35, 6
s_sub_u32 s58, s58, s59
s_max_i32 s58, s58, 0
s_lshr_b32 s63, s58, 6
s_mul_i32 s59, s35, 3
s_add_u32 s59, s59, s34
s_cmp_eq_u32 s59, 3
s_cselect_b32 s59, 4, 8
s_mul_i32 s34, s29, 448
s_add_u32 s58, s58, s34
s_lshl_b32 s48, s29, 2
s_add_u32 s48, s48, s56
s_lshl_b32 s48, s48, 5
s_and_b32 s51, s30, 7
s_lshl_b32 s51, s51, 2
s_add_u32 s48, s48, s51
s_add_u32 s48, s48, s31
s_lshl_b32 s48, s48, 8
s_add_u32 s48, s48, 65536
v_lshlrev_b32 v32, 6, v4
v_lshl_add_u32 v32, v5, 3, v32
v_add_u32 v32, s48, v32
v_mov_b32 v28, 0x7f000000
v_cmp_gt_u32 vcc, 8, v5
s_nop 1
v_cndmask_b32 v32, v28, v32, vcc
s_lshr_b32 s35, s31, 1
s_add_u32 s48, s35, s63
s_lshl_b32 s51, s29, 3
s_add_u32 s48, s48, s51
s_lshl_b32 s48, s48, 3
s_bfe_u32 s51, s30, 0x10002
s_lshl_b32 s51, s51, 2
s_add_u32 s48, s48, s51
s_add_u32 s48, s48, s56
s_lshl_b32 s48, s48, 10
s_and_b32 s51, s31, 1
s_lshl_b32 s51, s51, 7
s_add_u32 s48, s48, s51
s_add_u32 s48, s48, 589824
s_cmp_eq_u32 s59, 4
s_cselect_b32 s51, s35, 0
s_cmp_eq_u32 s51, 0
s_cselect_b32 s66, 0, 0x20000000
s_add_u32 s67, s66, s62
v_lshlrev_b32 v33, 8, v4
v_lshl_add_u32 v33, v5, 3, v33
v_add_u32 v33, s48, v33
v_lshrrev_b32 v24, 2, v5
v_and_b32 v25, 3, v5
v_lshl_add_u32 v26, v4, 2, v24
v_bfe_u32 v27, v26, 1, 2
v_xor_b32 v27, s31, v27
v_lshlrev_b32 v27, 5, v27
v_lshlrev_b32 v39, 7, v26
v_add_u32 v39, v39, v27
v_lshl_add_u32 v39, v25, 3, v39
v_mul_u32_u24 v40, 320, v25
v_lshl_add_u32 v40, v4, 4, v40
v_add_u32 v40, 57344, v40
v_bfe_u32 v28, v1, 2, 2
v_lshlrev_b32 v41, 6, v28
v_and_b32 v28, 1, v1
v_lshl_add_u32 v41, v28, 5, v41
v_bfe_u32 v28, v1, 1, 1
v_lshl_add_u32 v41, v28, 3, v41
s_mul_i32 s34, s31, 320
s_add_u32 s34, s34, 57344
v_add_u32 v41, s34, v41
s_mov_b32 s40, 0xffff0000
s_mov_b32 s41, 0
s_mov_b32 s42, 0
s_mov_b32 s43, 0x0000ffff
s_mov_b32 s44, 0
s_mov_b32 s45, 0xffff0000
s_mov_b32 s48, 0x3f803f80
s_waitcnt vmcnt(4)
v_mov_b32 v20, 0
v_mov_b32 v21, 0
v_dot2_f32_bf16 v20, v16, s48, v20
v_dot2_f32_bf16 v21, v16, v16, v21
v_dot2_f32_bf16 v20, v17, s48, v20
v_dot2_f32_bf16 v21, v17, v17, v21
v_dot2_f32_bf16 v20, v18, s48, v20
v_dot2_f32_bf16 v21, v18, v18, v21
v_dot2_f32_bf16 v20, v19, s48, v20
v_dot2_f32_bf16 v21, v19, v19, v21
s_nop 2
v_add_f32_dpp v20, v20, v20 row_ror:1 row_mask:0xf bank_mask:0xf
v_add_f32_dpp v21, v21, v21 row_ror:1 row_mask:0xf bank_mask:0xf
s_nop 0
v_add_f32_dpp v20, v20, v20 row_ror:2 row_mask:0xf bank_mask:0xf
v_add_f32_dpp v21, v21, v21 row_ror:2 row_mask:0xf bank_mask:0xf
s_nop 0
v_add_f32_dpp v20, v20, v20 row_ror:4 row_mask:0xf bank_mask:0xf
v_add_f32_dpp v21, v21, v21 row_ror:4 row_mask:0xf bank_mask:0xf
s_nop 0
v_add_f32_dpp v20, v20, v20 row_ror:8 row_mask:0xf bank_mask:0xf
v_add_f32_dpp v21, v21, v21 row_ror:8 row_mask:0xf bank_mask:0xf
s_nop 0
v_mov_b32 v22, v20
v_mov_b32 v23, v21
s_nop 0
v_permlane16_swap_b32 v20, v22
v_permlane16_swap_b32 v21, v23
v_add_f32 v20, v20, v22
v_add_f32 v21, v21, v23
v_mov_b32 v22, v20
v_mov_b32 v23, v21
s_nop 0
v_permlane32_swap_b32 v20, v22
v_permlane32_swap_b32 v21, v23
v_add_f32 v20, v20, v22
v_add_f32 v21, v21, v23
v_mul_f32 v20, 0x3b000000, v20
v_mul_f32 v21, 0x3b000000, v21
v_fma_f32 v21, -v20, v20, v21
v_max_f32 v21, 0, v21
v_add_f32 v21, 0x3727c5ac, v21
v_rsq_f32 v21, v21
s_nop 0
v_mul_f32 v20, v20, v21
v_lshlrev_b32 v56, 16, v16
v_and_b32 v57, 0xffff0000, v16
v_lshlrev_b32 v58, 16, v17
v_and_b32 v59, 0xffff0000, v17
v_lshlrev_b32 v60, 16, v18
v_and_b32 v61, 0xffff0000, v18
v_lshlrev_b32 v62, 16, v19
v_and_b32 v63, 0xffff0000, v19
v_fma_f32 v56, v56, v21, -v20
v_fma_f32 v57, v57, v21, -v20
v_fma_f32 v58, v58, v21, -v20
v_fma_f32 v59, v59, v21, -v20
v_fma_f32 v60, v60, v21, -v20
v_fma_f32 v61, v61, v21, -v20
v_fma_f32 v62, v62, v21, -v20
v_fma_f32 v63, v63, v21, -v20
v_cvt_pk_bf16_f32 v16, v56, v57
v_cvt_pk_bf16_f32 v17, v58, v59
v_cvt_pk_bf16_f32 v18, v60, v61
v_cvt_pk_bf16_f32 v19, v62, v63
s_lshl_b32 s48, s56, 4
s_lshl_b64 exec, 0xffff, s48
ds_write2_b64 v41, v[16:17], v[18:19] offset0:0 offset1:2
s_mov_b64 exec, -1
s_mov_b64 exec, 1
v_mov_b32 v20, 69520
v_mov_b32 v21, 1
ds_add_u32 v20, v21
s_mov_b64 exec, -1
v_lshlrev_b32 v30, 4, v1
s_lshl_b32 s34, s29, 7
s_lshl_b32 s35, s31, 3
s_add_u32 s34, s34, s35
s_lshl_b32 s34, s34, 8
s_lshr_b32 s35, s30, 3
s_lshl_b32 s35, s35, 6
s_add_u32 s34, s34, s35
s_add_u32 s34, s34, 65536
v_lshrrev_b32 v28, 5, v1
v_lshlrev_b32 v34, 13, v28
v_bfe_u32 v28, v1, 2, 3
v_lshl_add_u32 v34, v28, 8, v34
v_and_b32 v29, 3, v1
v_lshl_add_u32 v34, v29, 4, v34
v_add_u32 v34, s34, v34
v_add_u32 v35, 0x4000, v34
s_mul_i32 s35, s31, 320
s_add_u32 s35, s35, 58624
v_lshlrev_b32 v38, 5, v28
v_lshl_add_u32 v38, v29, 2, v38
v_add_u32 v38, s35, v38
v_lshrrev_b32 v28, 3, v1
v_and_b32 v29, 7, v1
v_lshlrev_b32 v31, 1, v4
v_xor_b32 v29, v29, v31
v_cmp_gt_u32 vcc, s59, v29
v_lshlrev_b32 v29, 4, v29
v_mul_u32_u24 v48, 3584, v28
v_add_u32 v48, v48, v29
v_add_u32 v48, s58, v48
v_mov_b32 v28, 0x7f000000
v_cndmask_b32 v48, v28, v48, vcc
s_and_b32 s34, s30, 3
s_lshl_b32 s34, s34, 8
v_xor_b32 v29, v5, v31
v_lshlrev_b32 v29, 4, v29
v_add_u32 v29, s34, v29
v_lshl_add_u32 v49, v4, 13, v29
v_xor_b32 v50, 128, v49
v_lshl_add_u32 v51, v4, 10, v29
v_xor_b32 v52, 128, v51
v_and_b32 v28, 7, v26
v_lshlrev_b32 v28, 5, v28
v_lshl_add_u32 v28, v25, 3, v28
v_lshl_add_u32 v28, v26, 8, v28
s_lshl_b32 s34, s31, 6
v_xor_b32 v42, s34, v28
v_add_u32 v42, 32768, v42
v_xor_b32 v43, 32, v42
v_mul_u32_u24 v44, 192, v25
v_lshl_add_u32 v44, v4, 4, v44
v_add_u32 v44, 68480, v44
v_lshlrev_b32 v45, 6, v25
v_lshl_add_u32 v45, v4, 4, v45
v_add_u32 v45, 69248, v45
s_and_b32 s34, s30, 3
s_lshl_b32 s34, s34, 5
s_lshl_b32 s35, s31, 1
s_add_u32 s34, s34, s35
s_lshl_b32 s34, s34, 12
s_lshl_b32 s35, s29, 3
s_lshr_b32 s48, s30, 2
s_add_u32 s35, s35, s48
s_lshl_b32 s35, s35, 6
s_add_u32 s34, s34, s35
s_add_u32 s34, s34, 2097152
v_lshlrev_b32 v46, 15, v4
v_lshrrev_b32 v28, 3, v5
v_lshl_add_u32 v46, v28, 12, v46
v_and_b32 v28, 7, v5
v_lshl_add_u32 v46, v28, 3, v46
v_add_u32 v46, s34, v46
s_lshr_b32 s57, s30, 2
s_lshl_b32 s48, s56, 7
s_lshl_b32 s34, s31, 5
s_add_u32 s48, s48, s34
s_mul_i32 s48, s48, 3584
s_lshl_b32 s49, s29, 9
s_lshl_b32 s34, s57, 6
s_add_u32 s49, s49, s34
s_lshr_b32 s34, s31, 1
s_lshl_b32 s34, s34, 5
s_add_u32 s49, s49, s34
s_and_b32 s34, s31, 1
s_lshl_b32 s34, s34, 2
s_add_u32 s49, s49, s34
s_lshl_b32 s49, s49, 10
s_mul_i32 s51, s29, 224
s_lshl_b32 s34, s57, 5
s_add_u32 s51, s51, s34
s_lshl_b32 s34, s31, 3
s_add_u32 s51, s51, s34
s_lshl_b32 s51, s51, 10
s_cmp_ge_u32 s57, 7
s_cselect_b32 s51, 0x7f000000, s51
s_waitcnt vmcnt(0)
s_mov_b64 exec, 1
v_mov_b32 v20, 69520
v_mov_b32 v21, 1
ds_add_u32 v20, v21
s_mov_b64 exec, -1
s_mov_b32 s60, 0
v_mov_b32 v20, 69520
L_w3:
ds_read_b32 v21, v20
s_waitcnt lgkmcnt(0)
v_readfirstlane_b32 s34, v21
s_add_u32 s60, s60, 1
s_cmp_ge_u32 s60, 1048576
s_cbranch_scc1 L_fail1
s_cmp_ge_u32 s34, 8
s_cbranch_scc1 L_w3_ok
s_branch L_w3
L_w3_ok:
s_mul_i32 s32, s33, 0x9E3779B1
s_add_u32 s32, s32, 0x7F4A7C15
s_or_b32 s32, s32, 1
ds_read_b128 v[56:59], v40 offset:0
ds_read_b128 v[60:63], v40 offset:64
ds_read_b128 v[64:67], v40 offset:128
ds_read_b128 v[68:71], v40 offset:192
s_waitcnt lgkmcnt(0)
ds_read_b64_tr_b16 v[76:77], v39 offset:0
ds_read_b64_tr_b16 v[78:79], v39 offset:2048
ds_read_b64_tr_b16 v[80:81], v39 offset:4096
ds_read_b64_tr_b16 v[82:83], v39 offset:6144
ds_read_b64_tr_b16 v[84:85], v39 offset:8192
ds_read_b64_tr_b16 v[86:87], v39 offset:10240
ds_read_b64_tr_b16 v[88:89], v39 offset:12288
ds_read_b64_tr_b16 v[90:91], v39 offset:14336
s_waitcnt lgkmcnt(6)
v_mfma_f32_16x16x32_bf16 v[72:75], v[56:59], v[76:79], 0
s_waitcnt lgkmcnt(4)
v_mfma_f32_16x16x32_bf16 v[72:75], v[60:63], v[80:83], v[72:75]
s_waitcnt lgkmcnt(2)
v_mfma_f32_16x16x32_bf16 v[72:75], v[64:67], v[84:87], v[72:75]
s_waitcnt lgkmcnt(0)
v_mfma_f32_16x16x32_bf16 v[72:75], v[68:71], v[88:91], v[72:75]
v_mov_b32 v21, s32
s_nop 6
v_cndmask_b32 v20, v72, v73, s[40:41]
v_cndmask_b32 v20, v20, v74, s[42:43]
v_cndmask_b32 v20, v20, v75, s[44:45]
s_nop 1
v_mov_b32_dpp v22, v20 row_ror:8 row_mask:0xf bank_mask:0xf
v_cvt_pk_bf16_f32 v20, v20, v22
buffer_store_dwordx2 v[20:21], v32, s[36:39], 0 offen
v_mov_b32 v18, v20
v_mov_b32 v19, v21
s_mov_b32 s60, 0
v_mov_b32 v20, 69504
L_w4:
ds_read_b32 v21, v20
s_waitcnt lgkmcnt(0)
v_readfirstlane_b32 s34, v21
s_add_u32 s60, s60, 1
s_cmp_ge_u32 s60, 1048576
s_cbranch_scc1 L_fail11
s_cmp_ge_u32 s34, 4
s_cbranch_scc1 L_w4_ok
s_sleep 1
s_branch L_w4
L_w4_ok:
s_mov_b32 s54, 0
s_cmp_eq_u32 s31, 3
s_cbranch_scc0 L_A_noloc1
s_lshl_b32 s34, s29, 8
s_add_u32 s34, s34, 32768
v_and_b32 v28, 31, v1
v_lshlrev_b32 v28, 3, v28
v_add_u32 v28, s34, v28
buffer_load_dwordx2 v[92:93], v28, s[36:39], 0 offen sc1
L_A_noloc1:
buffer_load_dwordx4 v[76:79], v34, s[36:39], 0 offen sc1
buffer_load_dwordx4 v[80:83], v35, s[36:39], 0 offen sc1
s_waitcnt vmcnt(0)
s_cmp_eq_u32 s31, 3
s_cbranch_scc0 L_A_noloc2
s_getreg_b32 s34, hwreg(HW_REG_XCC_ID)
v_xor_b32 v28, s32, v93
v_bitop3_b32 v28, v92, s34, v28 bitop3:0xbe
v_cmp_ne_u32 vcc, 0, v28
s_cmp_eq_u64 vcc, 0
s_cselect_b32 s34, 1, 2
v_mov_b32 v28, 69536
v_mov_b32 v29, s34
ds_write_b32 v28, v29
L_A_noloc2:
v_xor_b32 v24, s32, v77
v_bitop3_b32 v24, v79, s32, v24 bitop3:0xbe
v_bitop3_b32 v24, v81, s32, v24 bitop3:0xbe
v_bitop3_b32 v24, v83, s32, v24 bitop3:0xbe
v_cmp_ne_u32 vcc, 0, v24
s_cbranch_vccz L_q_ok2
s_mov_b32 s60, 0
L_qpoll:
buffer_load_dwordx4 v[76:79], v34, s[36:39], s61 offen sc1
buffer_load_dwordx4 v[80:83], v35, s[36:39], s61 offen sc1
s_waitcnt vmcnt(0)
v_xor_b32 v24, s32, v77
v_bitop3_b32 v24, v79, s32, v24 bitop3:0xbe
v_bitop3_b32 v24, v81, s32, v24 bitop3:0xbe
v_bitop3_b32 v24, v83, s32, v24 bitop3:0xbe
v_cmp_ne_u32 vcc, 0, v24
s_add_u32 s60, s60, 1
s_and_b64 exec, exec, vcc
s_cbranch_scc0 L_qpoll_ok
s_mov_b64 s[46:47], exec
s_mov_b64 exec, -1
v_mov_b32 v28, 69536
ds_read_b32 v29, v28
s_waitcnt lgkmcnt(0)
v_readfirstlane_b32 s34, v29
s_mov_b64 exec, s[46:47]
s_cmp_eq_u32 s34, 2
s_cbranch_scc0 L_qpoll_nz
s_cmp_eq_u32 s54, 0
s_cbranch_scc0 L_qpoll_gc
s_mov_b64 s[46:47], exec
s_mov_b64 exec, -1
buffer_store_dwordx2 v[18:19], v32, s[36:39], s62 offen sc1
s_mov_b64 exec, s[46:47]
s_mov_b32 s54, 1
L_qpoll_gc:
L_qpoll_nz:
s_cmp_ge_u32 s60, 64
s_cselect_b32 s34, s62, 0
s_xor_b32 s61, s61, s34
s_cmp_lt_u32 s60, 65536
s_cbranch_scc1 L_qpoll
s_branch L_fail2
L_qpoll_ok:
s_mov_b64 exec, -1
s_mov_b32 s61, 0
L_q_ok2:
s_mov_b32 s60, 0
v_mov_b32 v28, 69536
L_w5:
ds_read_b32 v29, v28
s_waitcnt lgkmcnt(0)
v_readfirstlane_b32 s34, v29
s_add_u32 s60, s60, 1
s_cmp_ge_u32 s60, 1048576
s_cbranch_scc1 L_fail14
s_cmp_ge_u32 s34, 1
s_cbranch_scc1 L_w5_ok
s_branch L_w5
L_w5_ok:
s_cmp_eq_u32 s34, 2
s_cbranch_scc0 L_q_nog
s_cmp_eq_u32 s54, 0
s_cbranch_scc0 L_q_gc2
s_mov_b64 s[46:47], exec
s_mov_b64 exec, -1
buffer_store_dwordx2 v[18:19], v32, s[36:39], s62 offen sc1
s_mov_b64 exec, s[46:47]
s_mov_b32 s54, 1
L_q_gc2:
L_q_nog:
v_lshlrev_b32 v84, 16, v76
v_and_b32 v85, 0xffff0000, v76
v_lshlrev_b32 v86, 16, v78
v_and_b32 v87, 0xffff0000, v78
v_lshlrev_b32 v88, 16, v80
v_and_b32 v89, 0xffff0000, v80
v_lshlrev_b32 v90, 16, v82
v_and_b32 v91, 0xffff0000, v82
v_pk_add_f32 v[84:85], v[84:85], v[88:89]
v_pk_add_f32 v[86:87], v[86:87], v[90:91]
v_mov_b32 v88, v84
v_mov_b32 v89, v85
v_mov_b32 v90, v86
v_mov_b32 v91, v87
v_permlane32_swap_b32 v84, v88
v_permlane32_swap_b32 v85, v89
v_permlane32_swap_b32 v86, v90
v_permlane32_swap_b32 v87, v91
v_add_f32 v84, v84, v88
v_add_f32 v85, v85, v89
v_add_f32 v86, v86, v90
v_add_f32 v87, v87, v91
v_cvt_pk_bf16_f32 v24, v84, v86
v_cvt_pk_bf16_f32 v25, v85, v87
ds_write_b32 v38, v24
ds_write_b32 v38, v25 offset:16
s_mov_b64 exec, 1
v_mov_b32 v20, 69512
v_mov_b32 v21, 1
ds_add_u32 v20, v21
s_mov_b64 exec, -1
s_bitcmp0_b32 s30, 2
s_cselect_b32 s68, s16, s18
s_cselect_b32 s69, s17, s19
s_mov_b32 s60, 0
v_mov_b32 v20, 69508
L_w6:
ds_read_b32 v21, v20
s_waitcnt lgkmcnt(0)
v_readfirstlane_b32 s34, v21
s_add_u32 s60, s60, 1
s_cmp_ge_u32 s60, 1048576
s_cbranch_scc1 L_fail9
s_cmp_ge_u32 s34, 4
s_cbranch_scc1 L_w6_ok
s_sleep 1
s_branch L_w6
L_w6_ok:
s_mov_b32 s4, s68
s_and_b32 s5, s69, 0xffff
s_mov_b32 s6, 1835008
s_mov_b32 s7, 0x20000
s_add_u32 m0, s50, 16384
s_nop 0
buffer_load_dwordx4 v48, s[4:7], s48 offen nt lds
s_add_u32 m0, s50, 17408
s_add_u32 s48, s48, 28672
buffer_load_dwordx4 v48, s[4:7], s48 offen nt lds
s_add_u32 m0, s50, 18432
s_add_u32 s48, s48, 28672
buffer_load_dwordx4 v48, s[4:7], s48 offen nt lds
s_add_u32 m0, s50, 19456
s_add_u32 s48, s48, 28672
buffer_load_dwordx4 v48, s[4:7], s48 offen nt lds
s_mov_b32 s8, s12
s_and_b32 s9, s13, 0xffff
s_mov_b32 s10, 4194304
s_mov_b32 s11, 0x20000
s_add_u32 m0, s50, 32768
s_nop 0
buffer_load_dwordx4 v49, s[8:11], s49 offen nt lds
s_add_u32 m0, s50, 33792
s_add_u32 s49, s49, 1024
buffer_load_dwordx4 v50, s[8:11], s49 offen nt lds
s_add_u32 m0, s50, 34816
s_add_u32 s49, s49, 1024
buffer_load_dwordx4 v49, s[8:11], s49 offen nt lds
s_add_u32 m0, s50, 35840
s_add_u32 s49, s49, 1024
buffer_load_dwordx4 v50, s[8:11], s49 offen nt lds
s_mov_b32 s16, s20
s_and_b32 s17, s21, 0xffff
s_mov_b32 s18, 1835008
s_mov_b32 s19, 0x20000
s_lshr_b32 s34, s50, 1
s_add_u32 m0, s34, 49152
s_nop 0
buffer_load_dwordx4 v51, s[16:19], s51 offen nt lds
s_add_u32 m0, s34, 50176
s_add_u32 s51, s51, 4096
buffer_load_dwordx4 v52, s[16:19], s51 offen nt lds
s_cmp_eq_u32 s31, 2
s_cbranch_scc1 L_A_adr2
s_cmp_eq_u32 s31, 3
s_cbranch_scc1 L_A_adr3
s_lshl_b32 s34, s29, 2
s_lshr_b32 s35, s57, 1
s_add_u32 s58, s34, s35
s_lshl_b32 s34, s58, 14
s_and_b32 s35, s57, 1
s_lshl_b32 s35, s35, 8
s_add_u32 s34, s34, s35
s_lshl_b32 s35, s31, 7
s_add_u32 s34, s34, s35
s_add_u32 s34, s34, 1179648
v_bfe_u32 v7, v1, 2, 2
v_and_b32 v8, 3, v1
v_lshlrev_b32 v53, 12, v4
v_lshl_add_u32 v53, v7, 9, v53
v_lshl_add_u32 v53, v8, 4, v53
v_add_u32 v53, s34, v53
s_lshl_b32 s34, s58, 8
s_add_u32 s34, s34, 1114112
v_lshlrev_b32 v54, 6, v4
v_lshl_add_u32 v54, v7, 3, v54
v_add_u32 v54, s34, v54
v_mul_u32_u24 v55, 192, v4
v_lshl_add_u32 v55, v8, 4, v55
s_lshl_b32 s34, s31, 6
s_add_u32 s34, s34, 68480
v_add_u32 v55, s34, v55
s_branch L_A_adrd
L_A_adr2:
s_lshl_b32 s34, s29, 3
s_add_u32 s34, s34, s57
s_lshl_b32 s34, s34, 13
s_add_u32 s34, s34, 589824
v_add_u32 v53, s34, v30
v_add_u32 v54, 4096, v53
v_bfe_u32 v7, v5, 1, 2
v_lshlrev_b32 v55, 6, v4
v_lshl_add_u32 v55, v7, 4, v55
v_lshrrev_b32 v7, 3, v5
v_lshl_add_u32 v55, v7, 3, v55
v_and_b32 v7, 1, v5
v_lshl_add_u32 v55, v7, 2, v55
v_add_u32 v55, 69248, v55
s_branch L_A_adrd
L_A_adr3:
s_lshl_b32 s34, s2, 12
s_add_u32 s34, s34, 2097152
v_add_u32 v53, s34, v30
s_lshr_b32 s34, s2, 3
s_and_b32 s34, s34, 3
s_lshl_b32 s34, s34, 10
s_lshr_b32 s35, s2, 5
s_and_b32 s35, s35, 3
s_lshl_b32 s35, s35, 8
s_add_u32 s34, s34, s35
s_and_b32 s35, s2, 7
s_lshl_b32 s35, s35, 5
s_add_u32 s34, s34, s35
v_and_b32 v54, 3, v1
v_lshlrev_b32 v54, 2, v54
v_add_u32 v54, s34, v54
v_mov_b32 v55, 0
L_A_adrd:
s_waitcnt vmcnt(6)
s_mov_b64 exec, 1
v_mov_b32 v20, 69524
v_mov_b32 v21, 1
ds_add_u32 v20, v21
s_mov_b64 exec, -1
s_mov_b32 s60, 0
v_mov_b32 v20, 69524
L_w7:
ds_read_b32 v21, v20
s_waitcnt lgkmcnt(0)
v_readfirstlane_b32 s34, v21
s_add_u32 s60, s60, 1
s_cmp_ge_u32 s60, 1048576
s_cbranch_scc1 L_fail12
s_cmp_ge_u32 s34, 4
s_cbranch_scc1 L_w7_ok
s_branch L_w7
L_w7_ok:
v_mov_b32 v22, 69536
ds_read_b32 v23, v22
ds_read_b64_tr_b16 v[76:77], v39 offset:16384
ds_read_b64_tr_b16 v[78:79], v39 offset:18432
ds_read_b64_tr_b16 v[80:81], v39 offset:20480
ds_read_b64_tr_b16 v[82:83], v39 offset:22528
ds_read_b64_tr_b16 v[84:85], v39 offset:24576
ds_read_b64_tr_b16 v[86:87], v39 offset:26624
ds_read_b64_tr_b16 v[88:89], v39 offset:28672
ds_read_b64_tr_b16 v[90:91], v39 offset:30720
s_waitcnt lgkmcnt(6)
v_mfma_f32_16x16x32_bf16 v[72:75], v[56:59], v[76:79], 0
s_waitcnt lgkmcnt(4)
v_mfma_f32_16x16x32_bf16 v[72:75], v[60:63], v[80:83], v[72:75]
s_waitcnt lgkmcnt(2)
v_mfma_f32_16x16x32_bf16 v[72:75], v[64:67], v[84:87], v[72:75]
s_waitcnt lgkmcnt(0)
v_mfma_f32_16x16x32_bf16 v[72:75], v[68:71], v[88:91], v[72:75]
v_mov_b32 v21, s32
s_nop 6
v_cndmask_b32 v20, v72, v73, s[40:41]
v_cndmask_b32 v20, v20, v74, s[42:43]
v_cndmask_b32 v20, v20, v75, s[44:45]
v_readfirstlane_b32 s34, v23
s_cmp_eq_u32 s34, 1
s_cselect_b32 s67, 0x20000000, s67
buffer_store_dwordx2 v[20:21], v33, s[36:39], s66 offen
buffer_store_dwordx2 v[20:21], v33, s[36:39], s67 offen sc1
s_waitcnt vmcnt(2)
s_mov_b64 exec, 1
v_mov_b32 v22, 69528
v_mov_b32 v23, 1
ds_add_u32 v22, v23
s_mov_b64 exec, -1
s_cmp_eq_u32 s31, 2
s_cbranch_scc1 L_A_h
s_cmp_eq_u32 s31, 3
s_cbranch_scc1 L_A_w3
buffer_load_dwordx2 v[92:93], v54, s[36:39], s61 offen sc1
buffer_load_dwordx2 v[94:95], v54, s[36:39], s61 offen offset:32 sc1
buffer_load_dwordx4 v[76:79], v53, s[36:39], s61 offen sc1
buffer_load_dwordx4 v[80:83], v53, s[36:39], s61 offen offset:64 sc1
buffer_load_dwordx4 v[84:87], v53, s[36:39], s61 offen offset:2048 sc1
buffer_load_dwordx4 v[88:91], v53, s[36:39], s61 offen offset:2112 sc1
s_mov_b32 s60, 0
v_mov_b32 v22, 69528
L_w8:
ds_read_b32 v23, v22
s_waitcnt lgkmcnt(0)
v_readfirstlane_b32 s34, v23
s_add_u32 s60, s60, 1
s_cmp_ge_u32 s60, 1048576
s_cbranch_scc1 L_fail13
s_cmp_ge_u32 s34, 4
s_cbranch_scc1 L_w8_ok
s_branch L_w8
L_w8_ok:
ds_read_b64_tr_b16 v[96:97], v42 offset:0
ds_read_b64_tr_b16 v[98:99], v42 offset:4096
ds_read_b64_tr_b16 v[100:101], v42 offset:8192
ds_read_b64_tr_b16 v[102:103], v42 offset:12288
ds_read_b64_tr_b16 v[104:105], v42 offset:16384
ds_read_b64_tr_b16 v[106:107], v42 offset:20480
ds_read_b64_tr_b16 v[108:109], v43 offset:0
ds_read_b64_tr_b16 v[110:111], v43 offset:4096
ds_read_b64_tr_b16 v[112:113], v43 offset:8192
ds_read_b64_tr_b16 v[114:115], v43 offset:12288
ds_read_b64_tr_b16 v[116:117], v43 offset:16384
ds_read_b64_tr_b16 v[118:119], v43 offset:20480
s_mov_b32 s60, 0
s_branch L_opoll_w
L_opoll:
buffer_load_dwordx2 v[92:93], v54, s[36:39], s61 offen sc1
buffer_load_dwordx2 v[94:95], v54, s[36:39], s61 offen offset:32 sc1
buffer_load_dwordx4 v[76:79], v53, s[36:39], s61 offen sc1
buffer_load_dwordx4 v[80:83], v53, s[36:39], s61 offen offset:64 sc1
buffer_load_dwordx4 v[84:87], v53, s[36:39], s61 offen offset:2048 sc1
buffer_load_dwordx4 v[88:91], v53, s[36:39], s61 offen offset:2112 sc1
L_opoll_w:
s_waitcnt vmcnt(0)
v_xor_b32 v24, s32, v77
v_bitop3_b32 v24, v79, s32, v24 bitop3:0xbe
v_bitop3_b32 v24, v81, s32, v24 bitop3:0xbe
v_bitop3_b32 v24, v83, s32, v24 bitop3:0xbe
v_bitop3_b32 v24, v85, s32, v24 bitop3:0xbe
v_bitop3_b32 v24, v87, s32, v24 bitop3:0xbe
v_bitop3_b32 v24, v89, s32, v24 bitop3:0xbe
v_bitop3_b32 v24, v91, s32, v24 bitop3:0xbe
v_bitop3_b32 v24, v93, s32, v24 bitop3:0xbe
v_bitop3_b32 v24, v95, s32, v24 bitop3:0xbe
v_cmp_ne_u32 vcc, 0, v24
s_add_u32 s60, s60, 1
s_and_b64 exec, exec, vcc
s_cbranch_scc0 L_opoll_ok
s_cmp_ge_u32 s60, 64
s_cselect_b32 s34, s62, 0
s_xor_b32 s61, s61, s34
s_cmp_lt_u32 s60, 65536
s_cbranch_scc1 L_opoll
s_branch L_fail4
L_opoll_ok:
s_mov_b64 exec, -1
s_mov_b32 s61, 0
v_max_f32 v24, v92, v94
s_nop 1
v_max_f32_dpp v24, v24, v24 row_ror:4 row_mask:0xf bank_mask:0xf
s_nop 1
v_max_f32_dpp v24, v24, v24 row_ror:8 row_mask:0xf bank_mask:0xf
v_sub_f32 v92, v92, v24
v_sub_f32 v94, v94, v24
v_exp_f32 v92, v92
v_exp_f32 v94, v94
v_lshlrev_b32 v140, 16, v76
v_and_b32 v141, 0xffff0000, v76
v_lshlrev_b32 v142, 16, v78
v_and_b32 v143, 0xffff0000, v78
v_lshlrev_b32 v144, 16, v80
v_and_b32 v145, 0xffff0000, v80
v_lshlrev_b32 v146, 16, v82
v_and_b32 v147, 0xffff0000, v82
v_add_f32 v24, v92, v94
v_lshlrev_b32 v148, 16, v84
v_and_b32 v149, 0xffff0000, v84
v_lshlrev_b32 v150, 16, v86
v_and_b32 v151, 0xffff0000, v86
v_add_f32_dpp v24, v24, v24 row_ror:4 row_mask:0xf bank_mask:0xf
v_lshlrev_b32 v152, 16, v88
v_and_b32 v153, 0xffff0000, v88
v_lshlrev_b32 v154, 16, v90
v_and_b32 v155, 0xffff0000, v90
v_add_f32_dpp v24, v24, v24 row_ror:8 row_mask:0xf bank_mask:0xf
v_rcp_f32 v24, v24
s_nop 0
v_mul_f32 v92, v92, v24
v_mul_f32 v94, v94, v24
v_pk_mul_f32 v[140:141], v[140:141], v[92:93] op_sel_hi:[1,0]
v_pk_mul_f32 v[142:143], v[142:143], v[92:93] op_sel_hi:[1,0]
v_pk_mul_f32 v[144:145], v[144:145], v[92:93] op_sel_hi:[1,0]
v_pk_mul_f32 v[146:147], v[146:147], v[92:93] op_sel_hi:[1,0]
v_pk_fma_f32 v[140:141], v[148:149], v[94:95], v[140:141] op_sel_hi:[1,0,1]
v_pk_fma_f32 v[142:143], v[150:151], v[94:95], v[142:143] op_sel_hi:[1,0,1]
v_pk_fma_f32 v[144:145], v[152:153], v[94:95], v[144:145] op_sel_hi:[1,0,1]
v_pk_fma_f32 v[146:147], v[154:155], v[94:95], v[146:147] op_sel_hi:[1,0,1]
v_add_f32_dpp v140, v140, v140 row_ror:4 row_mask:0xf bank_mask:0xf
v_add_f32_dpp v141, v141, v141 row_ror:4 row_mask:0xf bank_mask:0xf
v_add_f32_dpp v142, v142, v142 row_ror:4 row_mask:0xf bank_mask:0xf
v_add_f32_dpp v143, v143, v143 row_ror:4 row_mask:0xf bank_mask:0xf
v_add_f32_dpp v144, v144, v144 row_ror:4 row_mask:0xf bank_mask:0xf
v_add_f32_dpp v145, v145, v145 row_ror:4 row_mask:0xf bank_mask:0xf
v_add_f32_dpp v146, v146, v146 row_ror:4 row_mask:0xf bank_mask:0xf
v_add_f32_dpp v147, v147, v147 row_ror:4 row_mask:0xf bank_mask:0xf
v_add_f32_dpp v140, v140, v140 row_ror:8 row_mask:0xf bank_mask:0xf
v_add_f32_dpp v141, v141, v141 row_ror:8 row_mask:0xf bank_mask:0xf
v_add_f32_dpp v142, v142, v142 row_ror:8 row_mask:0xf bank_mask:0xf
v_add_f32_dpp v143, v143, v143 row_ror:8 row_mask:0xf bank_mask:0xf
v_add_f32_dpp v144, v144, v144 row_ror:8 row_mask:0xf bank_mask:0xf
v_add_f32_dpp v145, v145, v145 row_ror:8 row_mask:0xf bank_mask:0xf
v_add_f32_dpp v146, v146, v146 row_ror:8 row_mask:0xf bank_mask:0xf
v_add_f32_dpp v147, v147, v147 row_ror:8 row_mask:0xf bank_mask:0xf
v_cvt_pk_bf16_f32 v16, v140, v141
v_cvt_pk_bf16_f32 v17, v142, v143
v_cvt_pk_bf16_f32 v18, v144, v145
v_cvt_pk_bf16_f32 v19, v146, v147
ds_write_b128 v55, v[16:19]
s_mov_b64 exec, 1
v_mov_b32 v22, 69532
v_mov_b32 v23, 1
ds_add_u32 v22, v23
s_mov_b64 exec, -1
s_branch L_A_c
L_A_h:
v_mov_b32 v16, 0
s_cmp_ge_u32 s57, 7
s_cbranch_scc0 L_A_hg
s_mov_b32 s60, 0
v_mov_b32 v22, 69528
L_w9:
ds_read_b32 v23, v22
s_waitcnt lgkmcnt(0)
v_readfirstlane_b32 s34, v23
s_add_u32 s60, s60, 1
s_cmp_ge_u32 s60, 1048576
s_cbranch_scc1 L_fail13
s_cmp_ge_u32 s34, 4
s_cbranch_scc1 L_w9_ok
s_branch L_w9
L_w9_ok:
ds_read_b64_tr_b16 v[96:97], v42 offset:0
ds_read_b64_tr_b16 v[98:99], v42 offset:4096
ds_read_b64_tr_b16 v[100:101], v42 offset:8192
ds_read_b64_tr_b16 v[102:103], v42 offset:12288
ds_read_b64_tr_b16 v[104:105], v42 offset:16384
ds_read_b64_tr_b16 v[106:107], v42 offset:20480
ds_read_b64_tr_b16 v[108:109], v43 offset:0
ds_read_b64_tr_b16 v[110:111], v43 offset:4096
ds_read_b64_tr_b16 v[112:113], v43 offset:8192
ds_read_b64_tr_b16 v[114:115], v43 offset:12288
ds_read_b64_tr_b16 v[116:117], v43 offset:16384
ds_read_b64_tr_b16 v[118:119], v43 offset:20480
s_branch L_A_hw
L_A_hg:
buffer_load_dwordx4 v[140:143], v53, s[36:39], s61 offen sc1
buffer_load_dwordx4 v[144:147], v53, s[36:39], s61 offen offset:1024 sc1
buffer_load_dwordx4 v[148:151], v53, s[36:39], s61 offen offset:2048 sc1
buffer_load_dwordx4 v[152:155], v53, s[36:39], s61 offen offset:3072 sc1
buffer_load_dwordx4 v[76:79], v54, s[36:39], s61 offen sc1
buffer_load_dwordx4 v[80:83], v54, s[36:39], s61 offen offset:1024 sc1
buffer_load_dwordx4 v[84:87], v54, s[36:39], s61 offen offset:2048 sc1
buffer_load_dwordx4 v[88:91], v54, s[36:39], s61 offen offset:3072 sc1
s_mov_b32 s60, 0
v_mov_b32 v22, 69528
L_w10:
ds_read_b32 v23, v22
s_waitcnt lgkmcnt(0)
v_readfirstlane_b32 s34, v23
s_add_u32 s60, s60, 1
s_cmp_ge_u32 s60, 1048576
s_cbranch_scc1 L_fail13
s_cmp_ge_u32 s34, 4
s_cbranch_scc1 L_w10_ok
s_branch L_w10
L_w10_ok:
ds_read_b64_tr_b16 v[96:97], v42 offset:0
ds_read_b64_tr_b16 v[98:99], v42 offset:4096
ds_read_b64_tr_b16 v[100:101], v42 offset:8192
ds_read_b64_tr_b16 v[102:103], v42 offset:12288
ds_read_b64_tr_b16 v[104:105], v42 offset:16384
ds_read_b64_tr_b16 v[106:107], v42 offset:20480
ds_read_b64_tr_b16 v[108:109], v43 offset:0
ds_read_b64_tr_b16 v[110:111], v43 offset:4096
ds_read_b64_tr_b16 v[112:113], v43 offset:8192
ds_read_b64_tr_b16 v[114:115], v43 offset:12288
ds_read_b64_tr_b16 v[116:117], v43 offset:16384
ds_read_b64_tr_b16 v[118:119], v43 offset:20480
s_mov_b32 s60, 0
s_branch L_gpoll_w
L_gpoll:
buffer_load_dwordx4 v[140:143], v53, s[36:39], s61 offen sc1
buffer_load_dwordx4 v[144:147], v53, s[36:39], s61 offen offset:1024 sc1
buffer_load_dwordx4 v[148:151], v53, s[36:39], s61 offen offset:2048 sc1
buffer_load_dwordx4 v[152:155], v53, s[36:39], s61 offen offset:3072 sc1
buffer_load_dwordx4 v[76:79], v54, s[36:39], s61 offen sc1
buffer_load_dwordx4 v[80:83], v54, s[36:39], s61 offen offset:1024 sc1
buffer_load_dwordx4 v[84:87], v54, s[36:39], s61 offen offset:2048 sc1
buffer_load_dwordx4 v[88:91], v54, s[36:39], s61 offen offset:3072 sc1
L_gpoll_w:
s_waitcnt vmcnt(0)
v_xor_b32 v24, s32, v141
v_bitop3_b32 v24, v143, s32, v24 bitop3:0xbe
v_bitop3_b32 v24, v145, s32, v24 bitop3:0xbe
v_bitop3_b32 v24, v147, s32, v24 bitop3:0xbe
v_bitop3_b32 v24, v149, s32, v24 bitop3:0xbe
v_bitop3_b32 v24, v151, s32, v24 bitop3:0xbe
v_bitop3_b32 v24, v153, s32, v24 bitop3:0xbe
v_bitop3_b32 v24, v155, s32, v24 bitop3:0xbe
v_bitop3_b32 v24, v77, s32, v24 bitop3:0xbe
v_bitop3_b32 v24, v79, s32, v24 bitop3:0xbe
v_bitop3_b32 v24, v81, s32, v24 bitop3:0xbe
v_bitop3_b32 v24, v83, s32, v24 bitop3:0xbe
v_bitop3_b32 v24, v85, s32, v24 bitop3:0xbe
v_bitop3_b32 v24, v87, s32, v24 bitop3:0xbe
v_bitop3_b32 v24, v89, s32, v24 bitop3:0xbe
v_bitop3_b32 v24, v91, s32, v24 bitop3:0xbe
v_cmp_ne_u32 vcc, 0, v24
s_add_u32 s60, s60, 1
s_and_b64 exec, exec, vcc
s_cbranch_scc0 L_gpoll_ok
s_cmp_ge_u32 s60, 64
s_cselect_b32 s34, s62, 0
s_xor_b32 s61, s61, s34
s_cmp_lt_u32 s60, 65536
s_cbranch_scc1 L_gpoll
s_branch L_fail3
L_gpoll_ok:
s_mov_b64 exec, -1
s_mov_b32 s61, 0
v_add_f32 v140, v140, v144
v_add_f32 v148, v148, v152
v_add_f32 v142, v142, v146
v_add_f32 v150, v150, v154
v_add_f32 v140, v140, v148
v_add_f32 v142, v142, v150
v_add_f32 v76, v76, v80
v_add_f32 v84, v84, v88
v_add_f32 v78, v78, v82
v_add_f32 v86, v86, v90
v_add_f32 v76, v76, v84
v_add_f32 v78, v78, v86
s_mov_b32 s34, 0x3d372713
s_mov_b32 s35, 0xc0135761
v_mul_f32 v24, v140, v140
v_mul_f32 v25, v142, v142
v_fma_f32 v24, v24, s34, 1.0
v_fma_f32 v25, v25, s34, 1.0
v_mul_f32 v24, v24, v140
v_mul_f32 v25, v25, v142
v_mul_f32 v24, s35, v24
v_mul_f32 v25, s35, v25
v_exp_f32 v24, v24
v_exp_f32 v25, v25
s_nop 0
v_add_f32 v24, 1.0, v24
v_add_f32 v25, 1.0, v25
v_rcp_f32 v24, v24
v_rcp_f32 v25, v25
s_nop 0
v_mul_f32 v24, v24, v140
v_mul_f32 v25, v25, v142
v_mul_f32 v24, v24, v76
v_mul_f32 v25, v25, v78
v_cvt_pk_bf16_f32 v16, v24, v25
L_A_hw:
ds_write_b32 v55, v16
s_mov_b64 exec, 1
v_mov_b32 v22, 69532
v_mov_b32 v23, 1
ds_add_u32 v22, v23
s_mov_b64 exec, -1
s_branch L_A_c
L_A_w3:
s_mov_b32 s60, 0
v_mov_b32 v22, 69528
L_w11:
ds_read_b32 v23, v22
s_waitcnt lgkmcnt(0)
v_readfirstlane_b32 s34, v23
s_add_u32 s60, s60, 1
s_cmp_ge_u32 s60, 1048576
s_cbranch_scc1 L_fail13
s_cmp_ge_u32 s34, 4
s_cbranch_scc1 L_w11_ok
s_branch L_w11
L_w11_ok:
ds_read_b64_tr_b16 v[96:97], v42 offset:0
ds_read_b64_tr_b16 v[98:99], v42 offset:4096
ds_read_b64_tr_b16 v[100:101], v42 offset:8192
ds_read_b64_tr_b16 v[102:103], v42 offset:12288
ds_read_b64_tr_b16 v[104:105], v42 offset:16384
ds_read_b64_tr_b16 v[106:107], v42 offset:20480
ds_read_b64_tr_b16 v[108:109], v43 offset:0
ds_read_b64_tr_b16 v[110:111], v43 offset:4096
ds_read_b64_tr_b16 v[112:113], v43 offset:8192
ds_read_b64_tr_b16 v[114:115], v43 offset:12288
ds_read_b64_tr_b16 v[116:117], v43 offset:16384
ds_read_b64_tr_b16 v[118:119], v43 offset:20480
s_load_dwordx2 s[4:5], s[0:1], 0
s_load_dwordx2 s[8:9], s[0:1], 72
s_waitcnt lgkmcnt(0)
s_and_b32 s5, s5, 0xffff
s_mov_b32 s6, 4096
s_mov_b32 s7, 0x20000
s_and_b32 s9, s9, 0xffff
s_mov_b32 s10, 4096
s_mov_b32 s11, 0x20000
buffer_load_dword v31, v54, s[4:7], 0 offen
buffer_load_dword v30, v54, s[4:7], 0 offen offset:16
L_A_c:
v_mov_b32 v21, s32
v_mov_b32 v23, s32
s_mov_b32 s60, 0
v_mov_b32 v24, 69532
L_w12:
ds_read_b32 v25, v24
s_waitcnt lgkmcnt(0)
v_readfirstlane_b32 s34, v25
s_add_u32 s60, s60, 1
s_cmp_ge_u32 s60, 1048576
s_cbranch_scc1 L_fail10
s_cmp_ge_u32 s34, 3
s_cbranch_scc1 L_w12_ok
s_branch L_w12
L_w12_ok:
ds_read_b128 v[120:123], v44
ds_read_b128 v[124:127], v44 offset:64
ds_read_b128 v[128:131], v45
s_waitcnt lgkmcnt(0)
v_mfma_f32_16x16x32_bf16 v[132:135], v[128:131], v[104:107], 0
v_mfma_f32_16x16x32_bf16 v[136:139], v[128:131], v[116:119], 0
v_mfma_f32_16x16x32_bf16 v[132:135], v[120:123], v[96:99], v[132:135]
v_mfma_f32_16x16x32_bf16 v[136:139], v[120:123], v[108:111], v[136:139]
v_mfma_f32_16x16x32_bf16 v[132:135], v[124:127], v[100:103], v[132:135]
v_mfma_f32_16x16x32_bf16 v[136:139], v[124:127], v[112:115], v[136:139]
s_nop 7
v_cndmask_b32 v20, v132, v133, s[40:41]
v_cndmask_b32 v20, v20, v134, s[42:43]
v_cndmask_b32 v20, v20, v135, s[44:45]
v_cndmask_b32 v22, v136, v137, s[40:41]
v_cndmask_b32 v22, v22, v138, s[42:43]
v_cndmask_b32 v22, v22, v139, s[44:45]
s_mov_b32 s46, 0x00ff00ff
s_mov_b32 s47, 0x00ff00ff
v_mov_b32_dpp v24, v20 row_ror:8 row_mask:0xf bank_mask:0xf
v_mov_b32_dpp v25, v22 row_ror:8 row_mask:0xf bank_mask:0xf
v_cndmask_b32 v26, v25, v20, s[46:47]
v_cndmask_b32 v27, v22, v24, s[46:47]
v_cvt_pk_bf16_f32 v20, v26, v27
buffer_store_dwordx2 v[20:21], v46, s[36:39], 0 offen sc1
s_cmp_eq_u32 s31, 3
s_cbranch_scc0 L_A_done
s_cmp_lt_u32 s2, 128
s_cbranch_scc0 L_A_fin
s_sleep 10
s_mov_b32 s60, 0
L_dpoll:
buffer_load_dwordx4 v[76:79], v53, s[36:39], 0 offen sc1
buffer_load_dwordx4 v[80:83], v53, s[36:39], 0 offen offset:1024 sc1
buffer_load_dwordx4 v[84:87], v53, s[36:39], 0 offen offset:2048 sc1
buffer_load_dwordx4 v[88:91], v53, s[36:39], 0 offen offset:3072 sc1
s_waitcnt vmcnt(0)
v_xor_b32 v24, s32, v77
v_bitop3_b32 v24, v79, s32, v24 bitop3:0xbe
v_bitop3_b32 v24, v81, s32, v24 bitop3:0xbe
v_bitop3_b32 v24, v83, s32, v24 bitop3:0xbe
v_bitop3_b32 v24, v85, s32, v24 bitop3:0xbe
v_bitop3_b32 v24, v87, s32, v24 bitop3:0xbe
v_bitop3_b32 v24, v89, s32, v24 bitop3:0xbe
v_bitop3_b32 v24, v91, s32, v24 bitop3:0xbe
v_cmp_ne_u32 vcc, 0, v24
s_add_u32 s60, s60, 1
s_and_b64 exec, exec, vcc
s_cbranch_scc0 L_dpoll_ok
s_cmp_lt_u32 s60, 65536
s_cbranch_scc1 L_dpoll
s_branch L_fail5
L_dpoll_ok:
s_mov_b64 exec, -1
v_lshlrev_b32 v96, 16, v76
v_and_b32 v97, 0xffff0000, v76
v_lshlrev_b32 v98, 16, v78
v_and_b32 v99, 0xffff0000, v78
v_lshlrev_b32 v100, 16, v80
v_and_b32 v101, 0xffff0000, v80
v_lshlrev_b32 v102, 16, v82
v_and_b32 v103, 0xffff0000, v82
v_lshlrev_b32 v104, 16, v84
v_and_b32 v105, 0xffff0000, v84
v_lshlrev_b32 v106, 16, v86
v_and_b32 v107, 0xffff0000, v86
v_lshlrev_b32 v108, 16, v88
v_and_b32 v109, 0xffff0000, v88
v_lshlrev_b32 v110, 16, v90
v_and_b32 v111, 0xffff0000, v90
v_pk_add_f32 v[96:97], v[96:97], v[100:101]
v_pk_add_f32 v[98:99], v[98:99], v[102:103]
v_pk_add_f32 v[96:97], v[96:97], v[104:105]
v_pk_add_f32 v[98:99], v[98:99], v[106:107]
v_pk_add_f32 v[96:97], v[96:97], v[108:109]
v_pk_add_f32 v[98:99], v[98:99], v[110:111]
s_nop 0
v_add_f32_dpp v96, v96, v96 row_ror:4 row_mask:0xf bank_mask:0xf
v_add_f32_dpp v97, v97, v97 row_ror:4 row_mask:0xf bank_mask:0xf
v_add_f32_dpp v98, v98, v98 row_ror:4 row_mask:0xf bank_mask:0xf
v_add_f32_dpp v99, v99, v99 row_ror:4 row_mask:0xf bank_mask:0xf
v_add_f32_dpp v96, v96, v96 row_ror:8 row_mask:0xf bank_mask:0xf
v_add_f32_dpp v97, v97, v97 row_ror:8 row_mask:0xf bank_mask:0xf
v_add_f32_dpp v98, v98, v98 row_ror:8 row_mask:0xf bank_mask:0xf
v_add_f32_dpp v99, v99, v99 row_ror:8 row_mask:0xf bank_mask:0xf
v_mov_b32 v100, v96
v_mov_b32 v101, v97
v_mov_b32 v102, v98
v_mov_b32 v103, v99
v_permlane16_swap_b32 v96, v100
v_permlane16_swap_b32 v97, v101
v_permlane16_swap_b32 v98, v102
v_permlane16_swap_b32 v99, v103
v_add_f32 v96, v96, v100
v_add_f32 v97, v97, v101
v_add_f32 v98, v98, v102
v_add_f32 v99, v99, v103
v_mov_b32 v100, v96
v_mov_b32 v101, v97
v_mov_b32 v102, v98
v_mov_b32 v103, v99
v_permlane32_swap_b32 v96, v100
v_permlane32_swap_b32 v97, v101
v_permlane32_swap_b32 v98, v102
v_permlane32_swap_b32 v99, v103
v_add_f32 v96, v96, v100
v_add_f32 v97, v97, v101
v_add_f32 v98, v98, v102
v_add_f32 v99, v99, v103
v_lshlrev_b32 v20, 16, v31
v_and_b32 v21, 0xffff0000, v31
v_lshlrev_b32 v22, 16, v30
v_and_b32 v23, 0xffff0000, v30
v_add_f32 v96, v96, v20
v_add_f32 v98, v98, v21
v_add_f32 v97, v97, v22
v_add_f32 v99, v99, v23
v_cvt_pk_bf16_f32 v16, v96, v98
v_cvt_pk_bf16_f32 v17, v97, v99
s_mov_b64 exec, 15
buffer_store_dword v16, v54, s[8:11], 0 offen
buffer_store_dword v17, v54, s[8:11], 0 offen offset:16
s_cmp_eq_u32 s2, 0
s_cbranch_scc0 L_A_fin
s_mov_b64 exec, 1
v_mov_b32 v16, s32
v_mov_b32 v17, 0
buffer_store_dword v16, v17, s[36:39], 0 offen
L_A_fin:
L_A_done:
s_endpgm
L_fail1:
s_mov_b64 exec, 1
s_mov_b32 s40, s24
s_and_b32 s41, s25, 0xffff
s_mov_b32 s42, 256
s_mov_b32 s43, 0x20000
v_mov_b32 v2, 4
v_mov_b32 v3, s2
v_add_u32 v3, 0x10000, v3
buffer_store_dword v3, v2, s[40:43], 0 offen
s_endpgm
L_fail2:
s_mov_b64 exec, 1
s_mov_b32 s40, s24
s_and_b32 s41, s25, 0xffff
s_mov_b32 s42, 256
s_mov_b32 s43, 0x20000
v_mov_b32 v2, 8
v_mov_b32 v3, s2
v_add_u32 v3, 0x10000, v3
buffer_store_dword v3, v2, s[40:43], 0 offen
s_endpgm
L_fail3:
s_mov_b64 exec, 1
s_mov_b32 s40, s24
s_and_b32 s41, s25, 0xffff
s_mov_b32 s42, 256
s_mov_b32 s43, 0x20000
v_mov_b32 v2, 12
v_mov_b32 v3, s2
v_add_u32 v3, 0x10000, v3
buffer_store_dword v3, v2, s[40:43], 0 offen
s_endpgm
L_fail4:
s_mov_b64 exec, 1
s_mov_b32 s40, s24
s_and_b32 s41, s25, 0xffff
s_mov_b32 s42, 256
s_mov_b32 s43, 0x20000
v_mov_b32 v2, 16
v_mov_b32 v3, s2
v_add_u32 v3, 0x10000, v3
buffer_store_dword v3, v2, s[40:43], 0 offen
s_endpgm
L_fail5:
s_mov_b64 exec, 1
s_mov_b32 s40, s24
s_and_b32 s41, s25, 0xffff
s_mov_b32 s42, 256
s_mov_b32 s43, 0x20000
v_mov_b32 v2, 20
v_mov_b32 v3, s2
v_add_u32 v3, 0x10000, v3
buffer_store_dword v3, v2, s[40:43], 0 offen
s_endpgm
L_fail6:
s_mov_b64 exec, 1
s_mov_b32 s40, s24
s_and_b32 s41, s25, 0xffff
s_mov_b32 s42, 256
s_mov_b32 s43, 0x20000
v_mov_b32 v2, 24
v_mov_b32 v3, s2
v_add_u32 v3, 0x10000, v3
buffer_store_dword v3, v2, s[40:43], 0 offen
s_endpgm
L_fail8:
s_mov_b64 exec, 1
s_mov_b32 s40, s24
s_and_b32 s41, s25, 0xffff
s_mov_b32 s42, 256
s_mov_b32 s43, 0x20000
v_mov_b32 v2, 32
v_mov_b32 v3, s2
v_add_u32 v3, 0x10000, v3
buffer_store_dword v3, v2, s[40:43], 0 offen
s_endpgm
L_fail9:
s_mov_b64 exec, 1
s_mov_b32 s40, s24
s_and_b32 s41, s25, 0xffff
s_mov_b32 s42, 256
s_mov_b32 s43, 0x20000
v_mov_b32 v2, 36
v_mov_b32 v3, s2
v_add_u32 v3, 0x10000, v3
buffer_store_dword v3, v2, s[40:43], 0 offen
s_endpgm
L_fail10:
s_mov_b64 exec, 1
s_mov_b32 s40, s24
s_and_b32 s41, s25, 0xffff
s_mov_b32 s42, 256
s_mov_b32 s43, 0x20000
v_mov_b32 v2, 40
v_mov_b32 v3, s2
v_add_u32 v3, 0x10000, v3
buffer_store_dword v3, v2, s[40:43], 0 offen
s_endpgm
L_fail11:
s_mov_b64 exec, 1
s_mov_b32 s40, s24
s_and_b32 s41, s25, 0xffff
s_mov_b32 s42, 256
s_mov_b32 s43, 0x20000
v_mov_b32 v2, 44
v_mov_b32 v3, s2
v_add_u32 v3, 0x10000, v3
buffer_store_dword v3, v2, s[40:43], 0 offen
s_endpgm
L_fail12:
s_mov_b64 exec, 1
s_mov_b32 s40, s24
s_and_b32 s41, s25, 0xffff
s_mov_b32 s42, 256
s_mov_b32 s43, 0x20000
v_mov_b32 v2, 48
v_mov_b32 v3, s2
v_add_u32 v3, 0x10000, v3
buffer_store_dword v3, v2, s[40:43], 0 offen
s_endpgm
L_fail13:
s_mov_b64 exec, 1
s_mov_b32 s40, s24
s_and_b32 s41, s25, 0xffff
s_mov_b32 s42, 256
s_mov_b32 s43, 0x20000
v_mov_b32 v2, 52
v_mov_b32 v3, s2
v_add_u32 v3, 0x10000, v3
buffer_store_dword v3, v2, s[40:43], 0 offen
s_endpgm
L_fail14:
s_mov_b64 exec, 1
s_mov_b32 s40, s24
s_and_b32 s41, s25, 0xffff
s_mov_b32 s42, 256
s_mov_b32 s43, 0x20000
v_mov_b32 v2, 56
v_mov_b32 v3, s2
v_add_u32 v3, 0x10000, v3
buffer_store_dword v3, v2, s[40:43], 0 offen
s_endpgm
L_end:
s_endpgm
.section .rodata,"a"
.p2align 6
.amdhsa_kernel parallel_sum__sliding_block_cached__glu_gated_geglu__decode_kernel
  .amdhsa_next_free_vgpr 168
  .amdhsa_next_free_sgpr 102
  .amdhsa_accum_offset 168
  .amdhsa_group_segment_fixed_size 0
  .amdhsa_kernarg_size 96
  .amdhsa_user_sgpr_count 2
  .amdhsa_user_sgpr_kernarg_segment_ptr 1
  .amdhsa_system_sgpr_workgroup_id_x 1
.end_amdhsa_kernel
.text
```
